```python
import torch

def _softmax(x, axis=-1):
    return torch.softmax(x, dim=axis)
def _gelu(x):
    return torch.nn.functional.gelu(x, approximate="tanh")
def _silu(x):
    return torch.nn.functional.silu(x)
def _sigmoid(x):
    return torch.sigmoid(x)
def _layernorm(x, axis=-1, eps=1e-5):
    m = x.mean(dim=axis, keepdim=True)
    v = x.var(dim=axis, keepdim=True, unbiased=False)
    return (x - m) / torch.sqrt(v + eps)
def _scatter_add(tgt, idx, src, axis=0):
    return tgt.clone().index_add_(axis, idx, src)
def _segment_sum(src, seg, n):
    out = torch.zeros((n,) + src.shape[1:], dtype=src.dtype)
    return out.index_add_(0, seg, src)
def _pad(x, pw):
    flat = tuple(v for pair in reversed(pw) for v in pair)
    return torch.nn.functional.pad(x, flat)

kernel_name = 'standalone__fused_bias_dropout_add__prompt'

def setup_inputs():

    _w = (lambda a: (lambda t: t.to(torch.bfloat16) if t.is_floating_point() else t)(torch.as_tensor(a)))
    B, S, D = 4, 2048, 448
    keep = 0.9
    mask = (torch.rand(B, S, D) < keep).to(float)
    return {
        "x": _w((lambda *s: torch.randn(*s, dtype=torch.bfloat16) * 0.05)(B, S, D)),
        "bias": _w((lambda *s: torch.randn(*s, dtype=torch.bfloat16) * 0.05)(D)),
        "mask": _w(mask),
        "residual": _w((lambda *s: torch.randn(*s, dtype=torch.bfloat16) * 0.05)(B, S, D)),
    }

def reference(x, bias, mask, residual):
    keep = 0.9
    return residual + (x + bias) * mask * (1.0 / keep)
```

```asm
; @launch grid=(1024,1,1) block=(448,1,1) lds=0
.amdgcn_target "amdgcn-amd-amdhsa--gfx950"
.text
.globl standalone__fused_bias_dropout_add__prompt_kernel
.p2align 8
.type standalone__fused_bias_dropout_add__prompt_kernel,@function
standalone__fused_bias_dropout_add__prompt_kernel:
    s_load_dwordx8 s[4:11], s[0:1], 0
    s_load_dwordx2 s[12:13], s[0:1], 32
    s_cmp_ge_u32 s2, 1024
    s_cbranch_scc1 L_end
    s_mul_i32 s3, s2, 7168
    v_lshl_add_u32 v1, v0, 4, s3
    v_mul_u32_u24 v2, 0x493, v0
    v_lshrrev_b32 v2, 16, v2
    v_mul_u32_u24 v2, 56, v2
    v_sub_u32 v2, v0, v2
    v_lshlrev_b32 v2, 4, v2
    s_mov_b32 s14, 0x3f8e38e4
    s_mov_b32 s15, s14
    s_mov_b32 s16, 0xffff0000
    s_waitcnt lgkmcnt(0)
    global_load_dwordx4 v[4:7], v2, s[6:7]
    global_load_dwordx4 v[16:19], v1, s[4:5] nt
    global_load_dwordx4 v[20:23], v1, s[8:9] nt
    global_load_dwordx4 v[24:27], v1, s[10:11] nt
    s_cmp_lt_u32 s2, 512
    s_cbranch_scc1 L_wt
    s_waitcnt vmcnt(3)
    v_lshlrev_b32 v8, 16, v4
    v_and_b32 v9, s16, v4
    v_lshlrev_b32 v10, 16, v5
    v_and_b32 v11, s16, v5
    v_lshlrev_b32 v12, 16, v6
    v_and_b32 v13, s16, v6
    v_lshlrev_b32 v14, 16, v7
    v_and_b32 v15, s16, v7
    s_waitcnt vmcnt(2)
    v_lshlrev_b32 v28, 16, v16
    v_and_b32 v29, s16, v16
    v_lshlrev_b32 v30, 16, v17
    v_and_b32 v31, s16, v17
    v_lshlrev_b32 v32, 16, v18
    v_and_b32 v33, s16, v18
    v_lshlrev_b32 v34, 16, v19
    v_and_b32 v35, s16, v19
    v_pk_add_f32 v[8:9], v[28:29], v[8:9]
    v_pk_add_f32 v[10:11], v[30:31], v[10:11]
    v_pk_add_f32 v[12:13], v[32:33], v[12:13]
    v_pk_add_f32 v[14:15], v[34:35], v[14:15]
    v_cvt_pk_bf16_f32 v8, 0, v8
    v_cvt_pk_bf16_f32 v9, 0, v9
    v_cvt_pk_bf16_f32 v10, 0, v10
    v_cvt_pk_bf16_f32 v11, 0, v11
    v_cvt_pk_bf16_f32 v12, 0, v12
    v_cvt_pk_bf16_f32 v13, 0, v13
    v_cvt_pk_bf16_f32 v14, 0, v14
    v_cvt_pk_bf16_f32 v15, 0, v15
    v_pk_mul_f32 v[8:9], v[8:9], s[14:15]
    v_pk_mul_f32 v[10:11], v[10:11], s[14:15]
    v_pk_mul_f32 v[12:13], v[12:13], s[14:15]
    v_pk_mul_f32 v[14:15], v[14:15], s[14:15]
    v_cvt_pk_bf16_f32 v8, 0, v8
    v_cvt_pk_bf16_f32 v9, 0, v9
    v_cvt_pk_bf16_f32 v10, 0, v10
    v_cvt_pk_bf16_f32 v11, 0, v11
    v_cvt_pk_bf16_f32 v12, 0, v12
    v_cvt_pk_bf16_f32 v13, 0, v13
    v_cvt_pk_bf16_f32 v14, 0, v14
    v_cvt_pk_bf16_f32 v15, 0, v15
    s_waitcnt vmcnt(1)
    v_lshlrev_b32 v28, 16, v20
    v_and_b32 v29, s16, v20
    v_lshlrev_b32 v30, 16, v21
    v_and_b32 v31, s16, v21
    v_lshlrev_b32 v32, 16, v22
    v_and_b32 v33, s16, v22
    v_lshlrev_b32 v34, 16, v23
    v_and_b32 v35, s16, v23
    s_waitcnt vmcnt(0)
    v_lshlrev_b32 v16, 16, v24
    v_and_b32 v17, s16, v24
    v_lshlrev_b32 v18, 16, v25
    v_and_b32 v19, s16, v25
    v_lshlrev_b32 v4, 16, v26
    v_and_b32 v5, s16, v26
    v_lshlrev_b32 v6, 16, v27
    v_and_b32 v7, s16, v27
    v_pk_fma_f32 v[8:9], v[8:9], v[28:29], v[16:17]
    v_pk_fma_f32 v[10:11], v[10:11], v[30:31], v[18:19]
    v_pk_fma_f32 v[12:13], v[12:13], v[32:33], v[4:5]
    v_pk_fma_f32 v[14:15], v[14:15], v[34:35], v[6:7]
    v_cvt_pk_bf16_f32 v20, v8, v9
    v_cvt_pk_bf16_f32 v21, v10, v11
    v_cvt_pk_bf16_f32 v22, v12, v13
    v_cvt_pk_bf16_f32 v23, v14, v15
    global_store_dwordx4 v1, v[20:23], s[12:13]
    s_branch L_end
L_wt:
    s_waitcnt vmcnt(3)
    v_lshlrev_b32 v8, 16, v4
    v_and_b32 v9, s16, v4
    v_lshlrev_b32 v10, 16, v5
    v_and_b32 v11, s16, v5
    v_lshlrev_b32 v12, 16, v6
    v_and_b32 v13, s16, v6
    v_lshlrev_b32 v14, 16, v7
    v_and_b32 v15, s16, v7
    s_waitcnt vmcnt(2)
    v_lshlrev_b32 v28, 16, v16
    v_and_b32 v29, s16, v16
    v_lshlrev_b32 v30, 16, v17
    v_and_b32 v31, s16, v17
    v_lshlrev_b32 v32, 16, v18
    v_and_b32 v33, s16, v18
    v_lshlrev_b32 v34, 16, v19
    v_and_b32 v35, s16, v19
    v_pk_add_f32 v[8:9], v[28:29], v[8:9]
    v_pk_add_f32 v[10:11], v[30:31], v[10:11]
    v_pk_add_f32 v[12:13], v[32:33], v[12:13]
    v_pk_add_f32 v[14:15], v[34:35], v[14:15]
    v_cvt_pk_bf16_f32 v8, 0, v8
    v_cvt_pk_bf16_f32 v9, 0, v9
    v_cvt_pk_bf16_f32 v10, 0, v10
    v_cvt_pk_bf16_f32 v11, 0, v11
    v_cvt_pk_bf16_f32 v12, 0, v12
    v_cvt_pk_bf16_f32 v13, 0, v13
    v_cvt_pk_bf16_f32 v14, 0, v14
    v_cvt_pk_bf16_f32 v15, 0, v15
    v_pk_mul_f32 v[8:9], v[8:9], s[14:15]
    v_pk_mul_f32 v[10:11], v[10:11], s[14:15]
    v_pk_mul_f32 v[12:13], v[12:13], s[14:15]
    v_pk_mul_f32 v[14:15], v[14:15], s[14:15]
    v_cvt_pk_bf16_f32 v8, 0, v8
    v_cvt_pk_bf16_f32 v9, 0, v9
    v_cvt_pk_bf16_f32 v10, 0, v10
    v_cvt_pk_bf16_f32 v11, 0, v11
    v_cvt_pk_bf16_f32 v12, 0, v12
    v_cvt_pk_bf16_f32 v13, 0, v13
    v_cvt_pk_bf16_f32 v14, 0, v14
    v_cvt_pk_bf16_f32 v15, 0, v15
    s_waitcnt vmcnt(1)
    v_lshlrev_b32 v28, 16, v20
    v_and_b32 v29, s16, v20
    v_lshlrev_b32 v30, 16, v21
    v_and_b32 v31, s16, v21
    v_lshlrev_b32 v32, 16, v22
    v_and_b32 v33, s16, v22
    v_lshlrev_b32 v34, 16, v23
    v_and_b32 v35, s16, v23
    s_waitcnt vmcnt(0)
    v_lshlrev_b32 v16, 16, v24
    v_and_b32 v17, s16, v24
    v_lshlrev_b32 v18, 16, v25
    v_and_b32 v19, s16, v25
    v_lshlrev_b32 v4, 16, v26
    v_and_b32 v5, s16, v26
    v_lshlrev_b32 v6, 16, v27
    v_and_b32 v7, s16, v27
    v_pk_fma_f32 v[8:9], v[8:9], v[28:29], v[16:17]
    v_pk_fma_f32 v[10:11], v[10:11], v[30:31], v[18:19]
    v_pk_fma_f32 v[12:13], v[12:13], v[32:33], v[4:5]
    v_pk_fma_f32 v[14:15], v[14:15], v[34:35], v[6:7]
    v_cvt_pk_bf16_f32 v20, v8, v9
    v_cvt_pk_bf16_f32 v21, v10, v11
    v_cvt_pk_bf16_f32 v22, v12, v13
    v_cvt_pk_bf16_f32 v23, v14, v15
    global_store_dwordx4 v1, v[20:23], s[12:13] sc1
L_end:
    s_endpgm
.section .rodata,"a"
.p2align 6
.amdhsa_kernel standalone__fused_bias_dropout_add__prompt_kernel
  .amdhsa_next_free_vgpr 36
  .amdhsa_next_free_sgpr 24
  .amdhsa_accum_offset 36
  .amdhsa_group_segment_fixed_size 0
  .amdhsa_kernarg_size 56
  .amdhsa_user_sgpr_count 2
  .amdhsa_user_sgpr_kernarg_segment_ptr 1
  .amdhsa_system_sgpr_workgroup_id_x 1
  .amdhsa_float_denorm_mode_32 3
.end_amdhsa_kernel
```
